```python
import torch

def _softmax(x, axis=-1):
    return torch.softmax(x, dim=axis)

def _gelu(x):
    return torch.nn.functional.gelu(x, approximate='tanh')

def _silu(x):
    return torch.nn.functional.silu(x)

def _sigmoid(x):
    return torch.sigmoid(x)

def _layernorm(x, axis=-1, eps=1e-05):
    m = x.mean(dim=axis, keepdim=True)
    v = x.var(dim=axis, keepdim=True, unbiased=False)
    return (x - m) / torch.sqrt(v + eps)

def _scatter_add(tgt, idx, src, axis=0):
    return tgt.clone().index_add_(axis, idx, src)

def _segment_sum(src, seg, n):
    out = torch.zeros((n,) + src.shape[1:], dtype=src.dtype)
    return out.index_add_(0, seg, src)

def _pad(x, pw):
    flat = tuple((v for pair in reversed(pw) for v in pair))
    return torch.nn.functional.pad(x, flat)
kernel_name = 'standalone__tree_speculative_verify_tree_attention_over_candidate_token_tree__decode'

def setup_inputs():

    _w = lambda a: (lambda t: t.to(torch.bfloat16) if t.is_floating_point() else t)(torch.as_tensor(a))
    B, Hq, Hkv, T, C, D = (1, 16, 8, 1, 16384, 256)
    tree_mask = torch.zeros((B, T, T), dtype=float)
    for b in range(B):
        parent = torch.zeros(T, dtype=torch.int64)
        for i in range(1, T):
            parent[i] = int(torch.randint(0, i, (1,)).item())
        for i in range(T):
            j = i
            tree_mask[b, i, j] = 1.0
            while j > 0:
                j = parent[j]
                tree_mask[b, i, j] = 1.0
    return {'q': _w((lambda *s: torch.randn(*s, dtype=torch.bfloat16) * 0.8)(B, Hq, T, D)), 'k_cache': _w((lambda *s: torch.randn(*s, dtype=torch.bfloat16) * 0.8)(B, Hkv, C, D)), 'v_cache': _w((lambda *s: torch.randn(*s, dtype=torch.bfloat16) * 0.05)(B, Hkv, C, D)), 'k_tree': _w((lambda *s: torch.randn(*s, dtype=torch.bfloat16) * 0.8)(B, Hkv, T, D)), 'v_tree': _w((lambda *s: torch.randn(*s, dtype=torch.bfloat16) * 0.05)(B, Hkv, T, D)), 'tree_mask': _w(tree_mask)}

def reference(q, k_cache, v_cache, k_tree, v_tree, tree_mask):
    B, Hq, T, D = q.shape
    Hkv, C = (k_cache.shape[1], k_cache.shape[2])
    rep = Hq // Hkv
    kc = (lambda x, n, axis: torch.repeat_interleave(x, n, dim=axis))(k_cache, rep, axis=1)
    vc = (lambda x, n, axis: torch.repeat_interleave(x, n, dim=axis))(v_cache, rep, axis=1)
    kt = (lambda x, n, axis: torch.repeat_interleave(x, n, dim=axis))(k_tree, rep, axis=1)
    vt = (lambda x, n, axis: torch.repeat_interleave(x, n, dim=axis))(v_tree, rep, axis=1)
    k = torch.concatenate([kc, kt], axis=2)
    v = torch.concatenate([vc, vt], axis=2)
    scale = D ** (-0.5)
    scores = torch.einsum('bhqd,bhkd->bhqk', q, k) * scale
    ctx_mask = torch.ones((B, 1, T, C), dtype=scores.dtype)
    tm = tree_mask[:, None, :, :].clone()
    full_mask = torch.concatenate([ctx_mask, tm], axis=-1)
    scores = scores + (1.0 - full_mask) * -1000000000.0
    p = _softmax(scores, axis=-1)
    return torch.einsum('bhqk,bhkd->bhqd', p, v)
```

```asm
; @launch grid=(256,1,1) block=(320,1,1) lds=98560
.amdgcn_target "amdgcn-amd-amdhsa--gfx950"
.text
.globl standalone__tree_speculative_verify_tree_attention_over_candidate_token_tree__decode_kernel
.p2align 8
.type standalone__tree_speculative_verify_tree_attention_over_candidate_token_tree__decode_kernel,@function
standalone__tree_speculative_verify_tree_attention_over_candidate_token_tree__decode_kernel:
    s_load_dwordx16 s[4:19], s[0:1], 0
    s_load_dwordx2 s[20:21], s[0:1], 64
    s_cmp_ge_u32 s2, 256
    s_cbranch_scc1 L_exit
    v_lshrrev_b32 v3, 6, v0
    v_and_b32 v1, 63, v0
    v_readfirstlane_b32 s24, v3
    s_and_b32 s22, s2, 7
    s_lshr_b32 s23, s2, 3
    v_lshrrev_b32 v2, 4, v1
    s_cmp_eq_u32 s24, 4
    s_cbranch_scc1 L_helper
    v_lshrrev_b32 v20, 5, v1
    v_and_b32 v21, 31, v1
    v_lshlrev_b32 v22, 1, v20
    v_xor_b32 v21, v21, v22
    v_lshlrev_b32 v23, 9, v20
    v_xor_b32 v24, 0, v21
    v_lshl_add_u32 v4, v24, 4, v23
    v_xor_b32 v24, 4, v21
    v_lshl_add_u32 v5, v24, 4, v23
    v_xor_b32 v24, 8, v21
    v_lshl_add_u32 v6, v24, 4, v23
    v_xor_b32 v24, 12, v21
    v_lshl_add_u32 v7, v24, 4, v23
    s_mul_i32 s25, s24, 24576
    s_lshl_b32 s65, s23, 18
    s_lshl_b32 s76, s24, 12
    s_add_u32 s65, s65, s76
    s_sub_u32 s78, 0x800000, s65
    s_lshl_b32 s76, s22, 23
    s_add_u32 s65, s65, s76
    s_lshl_b32 s76, s22, 10
    s_lshl_b32 s77, s22, 9
    s_or_b32 s74, s23, s24
    s_mov_b32 s30, s78
    s_mov_b32 s31, 0x20000
    s_mov_b32 s34, s78
    s_mov_b32 s35, 0x20000
    s_mov_b32 s38, 0x400
    s_mov_b32 s39, 0x20000
    v_lshlrev_b32 v25, 4, v1
    s_mov_b32 m0, s25
    s_mov_b32 s64, 0
    s_waitcnt lgkmcnt(0)
    s_add_u32 s28, s6, s65
    s_addc_u32 s29, s7, 0
    buffer_load_dwordx4 v4, s[28:31], s64 offen nt lds
    buffer_load_dwordx4 v5, s[28:31], s64 offen offset:1024 nt lds
    buffer_load_dwordx4 v6, s[28:31], s64 offen offset:2048 nt lds
    buffer_load_dwordx4 v7, s[28:31], s64 offen offset:3072 nt lds
    s_add_u32 s36, s4, s76
    s_addc_u32 s37, s5, 0
    s_add_u32 m0, s25, 4096
    s_mov_b32 s64, 16384
    buffer_load_dwordx4 v4, s[28:31], s64 offen nt lds
    buffer_load_dwordx4 v5, s[28:31], s64 offen offset:1024 nt lds
    buffer_load_dwordx4 v6, s[28:31], s64 offen offset:2048 nt lds
    buffer_load_dwordx4 v7, s[28:31], s64 offen offset:3072 nt lds
    s_add_u32 s32, s8, s65
    s_addc_u32 s33, s9, 0
    v_lshrrev_b32 v20, 3, v1
    v_lshlrev_b32 v20, 11, v20
    v_and_b32 v21, 7, v1
    v_lshl_add_u32 v219, v21, 3, v20
    s_lshl_b32 s79, s22, 16
    s_lshl_b32 s64, s24, 14
    s_add_u32 s79, s79, s64
    s_lshl_b32 s64, s23, 6
    s_add_u32 s79, s79, s64
    s_mov_b32 s52, s20
    s_mov_b32 s53, s21
    s_mov_b32 s54, 0x100000
    s_mov_b32 s55, 0x20000
    buffer_load_dwordx2 v[222:223], v219, s[52:55], s79 offen sc1
    s_cmp_lg_u32 s74, 0
    s_cbranch_scc1 L_notree0
    s_add_u32 s40, s10, s77
    s_addc_u32 s41, s11, 0
    s_mov_b32 s42, 0x200
    s_mov_b32 s43, 0x20000
    s_add_u32 s44, s12, s77
    s_addc_u32 s45, s13, 0
    s_mov_b32 s46, 0x200
    s_mov_b32 s47, 0x20000
    s_mov_b32 s48, s14
    s_mov_b32 s49, s15
    s_mov_b32 s50, 0x2
    s_mov_b32 s51, 0x20000
    s_add_u32 m0, s25, 21504
    s_nop 0
    buffer_load_dwordx4 v25, s[40:43], 0 offen lds
    s_add_u32 m0, s25, 22528
    s_nop 0
    buffer_load_dwordx4 v25, s[44:47], 0 offen lds
    buffer_load_ushort v26, off, s[48:51], 0
L_notree0:
    s_add_u32 m0, s25, 20480
    s_nop 0
    buffer_load_dwordx4 v25, s[36:39], 0 offen lds
    s_add_u32 m0, s25, 8192
    s_mov_b32 s64, 32768
    buffer_load_dwordx4 v4, s[28:31], s64 offen nt lds
    buffer_load_dwordx4 v5, s[28:31], s64 offen offset:1024 nt lds
    buffer_load_dwordx4 v6, s[28:31], s64 offen offset:2048 nt lds
    buffer_load_dwordx4 v7, s[28:31], s64 offen offset:3072 nt lds
    s_add_u32 m0, s25, 12288
    s_mov_b32 s64, 49152
    buffer_load_dwordx4 v4, s[28:31], s64 offen nt lds
    buffer_load_dwordx4 v5, s[28:31], s64 offen offset:1024 nt lds
    buffer_load_dwordx4 v6, s[28:31], s64 offen offset:2048 nt lds
    buffer_load_dwordx4 v7, s[28:31], s64 offen offset:3072 nt lds
    s_add_u32 m0, s25, 16384
    s_mov_b32 s64, 65536
    buffer_load_dwordx4 v4, s[28:31], s64 offen nt lds
    buffer_load_dwordx4 v5, s[28:31], s64 offen offset:1024 nt lds
    buffer_load_dwordx4 v6, s[28:31], s64 offen offset:2048 nt lds
    buffer_load_dwordx4 v7, s[28:31], s64 offen offset:3072 nt lds
    s_barrier
    v_and_b32 v20, 15, v1
    v_and_b32 v21, 7, v1
    v_lshlrev_b32 v21, 1, v21
    v_xor_b32 v21, v21, v2
    v_lshlrev_b32 v22, 9, v20
    v_add_u32 v22, s25, v22
    v_xor_b32 v23, 0, v21
    v_lshl_add_u32 v8, v23, 4, v22
    v_xor_b32 v23, 4, v21
    v_lshl_add_u32 v9, v23, 4, v22
    v_xor_b32 v23, 8, v21
    v_lshl_add_u32 v10, v23, 4, v22
    v_xor_b32 v23, 12, v21
    v_lshl_add_u32 v11, v23, 4, v22
    v_bfe_u32 v20, v1, 2, 2
    v_lshl_add_u32 v20, v2, 2, v20
    v_and_b32 v21, 7, v20
    v_and_b32 v22, 3, v1
    v_lshlrev_b32 v22, 3, v22
    v_lshl_add_u32 v22, v20, 9, v22
    v_add_u32 v22, s25, v22
    v_xor_b32 v23, 0, v21
    v_lshl_add_u32 v12, v23, 5, v22
    v_xor_b32 v23, 1, v21
    v_lshl_add_u32 v13, v23, 5, v22
    v_xor_b32 v23, 2, v21
    v_lshl_add_u32 v14, v23, 5, v22
    v_xor_b32 v23, 3, v21
    v_lshl_add_u32 v15, v23, 5, v22
    v_xor_b32 v23, 4, v21
    v_lshl_add_u32 v16, v23, 5, v22
    v_xor_b32 v23, 5, v21
    v_lshl_add_u32 v17, v23, 5, v22
    v_xor_b32 v23, 6, v21
    v_lshl_add_u32 v18, v23, 5, v22
    v_xor_b32 v23, 7, v21
    v_lshl_add_u32 v19, v23, 5, v22
    v_and_b32 v20, 1, v1
    v_lshlrev_b32 v20, 9, v20
    v_lshl_add_u32 v20, v2, 4, v20
    v_add_u32 v27, s25, v20
    v_lshlrev_b32 v220, 3, v1
    s_lshl_b32 s65, s24, 9
    v_add_u32 v217, s65, v220
    v_add_u32 v218, 0xc000, v217
    v_add_u32 v220, s25, v220
    v_mov_b32 v128, 0
    v_mov_b32 v129, 0
    v_mov_b32 v130, 0
    v_mov_b32 v131, 0
    v_mov_b32 v132, 0
    v_mov_b32 v133, 0
    v_mov_b32 v134, 0
    v_mov_b32 v135, 0
    v_mov_b32 v136, 0
    v_mov_b32 v137, 0
    v_mov_b32 v138, 0
    v_mov_b32 v139, 0
    v_mov_b32 v140, 0
    v_mov_b32 v141, 0
    v_mov_b32 v142, 0
    v_mov_b32 v143, 0
    v_mov_b32 v144, 0
    v_mov_b32 v145, 0
    v_mov_b32 v146, 0
    v_mov_b32 v147, 0
    v_mov_b32 v148, 0
    v_mov_b32 v149, 0
    v_mov_b32 v150, 0
    v_mov_b32 v151, 0
    v_mov_b32 v152, 0
    v_mov_b32 v153, 0
    v_mov_b32 v154, 0
    v_mov_b32 v155, 0
    v_mov_b32 v156, 0
    v_mov_b32 v157, 0
    v_mov_b32 v158, 0
    v_mov_b32 v159, 0
    v_mov_b32 v160, 0
    v_mov_b32 v161, 0
    v_mov_b32 v162, 0
    v_mov_b32 v163, 0
    v_mov_b32 v164, 0
    v_mov_b32 v165, 0
    v_mov_b32 v166, 0
    v_mov_b32 v167, 0
    v_mov_b32 v168, 0
    v_mov_b32 v169, 0
    v_mov_b32 v170, 0
    v_mov_b32 v171, 0
    v_mov_b32 v172, 0
    v_mov_b32 v173, 0
    v_mov_b32 v174, 0
    v_mov_b32 v175, 0
    v_mov_b32 v176, 0
    v_mov_b32 v177, 0
    v_mov_b32 v178, 0
    v_mov_b32 v179, 0
    v_mov_b32 v180, 0
    v_mov_b32 v181, 0
    v_mov_b32 v182, 0
    v_mov_b32 v183, 0
    v_mov_b32 v184, 0
    v_mov_b32 v185, 0
    v_mov_b32 v186, 0
    v_mov_b32 v187, 0
    v_mov_b32 v188, 0
    v_mov_b32 v189, 0
    v_mov_b32 v190, 0
    v_mov_b32 v191, 0
    v_mov_b32 v192, 0
    v_mov_b32 v193, 0
    v_mov_b32 v194, 0
    v_mov_b32 v195, 0
    v_mov_b32 v196, 0
    v_mov_b32 v197, 0
    v_mov_b32 v198, 0
    v_mov_b32 v199, 0
    v_mov_b32 v200, 0
    v_mov_b32 v201, 0
    v_mov_b32 v202, 0
    v_mov_b32 v203, 0
    v_mov_b32 v204, 0
    v_mov_b32 v205, 0
    v_mov_b32 v206, 0
    v_mov_b32 v207, 0
    s_mov_b32 s66, 0xf000f
    s_mov_b32 s67, 0xf000f
    s_mov_b32 s68, 0xf000f0
    s_mov_b32 s69, 0xf000f0
    s_mov_b32 s70, 0xf000f00
    s_mov_b32 s71, 0xf000f00
    s_mov_b32 s72, 0xf000f000
    s_mov_b32 s73, 0xf000f000
    s_mov_b32 s75, 0x3db8aa3b
    v_mov_b32 v216, 0xff61b1e6
    s_waitcnt vmcnt(12)
    v_not_b32 v222, v222
    v_not_b32 v223, v223
    v_and_b32 v222, 1, v222
    v_and_b32 v223, 1, v223
    ds_read_b128 v[32:35], v27 offset:20480
    ds_read_b128 v[36:39], v27 offset:20544
    ds_read_b128 v[40:43], v27 offset:20608
    ds_read_b128 v[44:47], v27 offset:20672
    ds_read_b128 v[48:51], v27 offset:20736
    ds_read_b128 v[52:55], v27 offset:20800
    ds_read_b128 v[56:59], v27 offset:20864
    ds_read_b128 v[60:63], v27 offset:20928
    s_cmp_lg_u32 s74, 0
    s_cbranch_scc1 L_notree1
    v_lshlrev_b32 v20, 4, v2
    v_add_u32 v20, s25, v20
    ds_read_b128 v[64:67], v20 offset:21504
    ds_read_b128 v[68:71], v20 offset:21568
    ds_read_b128 v[72:75], v20 offset:21632
    ds_read_b128 v[76:79], v20 offset:21696
    ds_read_b128 v[80:83], v20 offset:21760
    ds_read_b128 v[84:87], v20 offset:21824
    ds_read_b128 v[88:91], v20 offset:21888
    ds_read_b128 v[92:95], v20 offset:21952
    v_lshlrev_b32 v21, 1, v1
    v_add_u32 v21, s25, v21
    ds_read_u16 v212, v21 offset:22528
    ds_read_u16 v213, v21 offset:22656
    ds_read_u16 v214, v21 offset:22784
    ds_read_u16 v215, v21 offset:22912
    s_waitcnt lgkmcnt(0)
    v_mfma_f32_16x16x32_bf16 v[96:99], v[64:67], v[32:35], 0
    v_mfma_f32_16x16x32_bf16 v[96:99], v[68:71], v[36:39], v[96:99]
    v_mfma_f32_16x16x32_bf16 v[96:99], v[72:75], v[40:43], v[96:99]
    v_mfma_f32_16x16x32_bf16 v[96:99], v[76:79], v[44:47], v[96:99]
    v_mfma_f32_16x16x32_bf16 v[96:99], v[80:83], v[48:51], v[96:99]
    v_mfma_f32_16x16x32_bf16 v[96:99], v[84:87], v[52:55], v[96:99]
    v_mfma_f32_16x16x32_bf16 v[96:99], v[88:91], v[56:59], v[96:99]
    v_mfma_f32_16x16x32_bf16 v[96:99], v[92:95], v[60:63], v[96:99]
    v_lshlrev_b32 v212, 16, v212
    v_lshlrev_b32 v213, 16, v213
    v_lshlrev_b32 v214, 16, v214
    v_lshlrev_b32 v215, 16, v215
    v_lshlrev_b32 v26, 16, v26
    v_sub_f32 v26, 1.0, v26
    v_mul_f32 v26, 0xd06e6b28, v26
    s_nop 2
    v_add_f32 v216, v96, v26
L_notree1:
    s_waitcnt lgkmcnt(0)
    s_add_u32 m0, s25, 20480
    s_mov_b32 s64, 81920
    buffer_load_dwordx4 v4, s[28:31], s64 offen nt lds
    buffer_load_dwordx4 v5, s[28:31], s64 offen offset:1024 nt lds
    buffer_load_dwordx4 v6, s[28:31], s64 offen offset:2048 nt lds
    buffer_load_dwordx4 v7, s[28:31], s64 offen offset:3072 nt lds
    ds_read_b128 v[64:67], v8 offset:0
    ds_read_b128 v[68:71], v9 offset:0
    ds_read_b128 v[72:75], v10 offset:0
    ds_read_b128 v[76:79], v11 offset:0
    ds_read_b128 v[80:83], v8 offset:256
    ds_read_b128 v[84:87], v9 offset:256
    ds_read_b128 v[88:91], v10 offset:256
    ds_read_b128 v[92:95], v11 offset:256
    s_waitcnt lgkmcnt(0)
    s_add_u32 m0, s25, 0
    s_mov_b32 s64, 98304
    buffer_load_dwordx4 v4, s[28:31], s64 offen nt lds
    buffer_load_dwordx4 v5, s[28:31], s64 offen offset:1024 nt lds
    buffer_load_dwordx4 v6, s[28:31], s64 offen offset:2048 nt lds
    buffer_load_dwordx4 v7, s[28:31], s64 offen offset:3072 nt lds
    s_add_u32 m0, s25, 4096
    s_mov_b32 s64, 114688
    buffer_load_dwordx4 v4, s[28:31], s64 offen nt lds
    buffer_load_dwordx4 v5, s[28:31], s64 offen offset:1024 nt lds
    buffer_load_dwordx4 v6, s[28:31], s64 offen offset:2048 nt lds
    buffer_load_dwordx4 v7, s[28:31], s64 offen offset:3072 nt lds
    v_mfma_f32_16x16x32_bf16 v[96:99], v[64:67], v[32:35], 0
    v_mfma_f32_16x16x32_bf16 v[96:99], v[68:71], v[36:39], v[96:99]
    v_mfma_f32_16x16x32_bf16 v[96:99], v[72:75], v[40:43], v[96:99]
    v_mfma_f32_16x16x32_bf16 v[96:99], v[76:79], v[44:47], v[96:99]
    v_mfma_f32_16x16x32_bf16 v[96:99], v[80:83], v[48:51], v[96:99]
    v_mfma_f32_16x16x32_bf16 v[96:99], v[84:87], v[52:55], v[96:99]
    v_mfma_f32_16x16x32_bf16 v[96:99], v[88:91], v[56:59], v[96:99]
    v_mfma_f32_16x16x32_bf16 v[96:99], v[92:95], v[60:63], v[96:99]
    s_waitcnt vmcnt(16)
    ds_read_b128 v[64:67], v8 offset:8192
    ds_read_b128 v[68:71], v9 offset:8192
    ds_read_b128 v[72:75], v10 offset:8192
    ds_read_b128 v[76:79], v11 offset:8192
    ds_read_b128 v[80:83], v8 offset:8448
    ds_read_b128 v[84:87], v9 offset:8448
    ds_read_b128 v[88:91], v10 offset:8448
    ds_read_b128 v[92:95], v11 offset:8448
    s_waitcnt lgkmcnt(0)
    s_add_u32 m0, s25, 8192
    s_mov_b32 s64, 131072
    buffer_load_dwordx4 v4, s[28:31], s64 offen nt lds
    buffer_load_dwordx4 v5, s[28:31], s64 offen offset:1024 nt lds
    buffer_load_dwordx4 v6, s[28:31], s64 offen offset:2048 nt lds
    buffer_load_dwordx4 v7, s[28:31], s64 offen offset:3072 nt lds
    s_add_u32 m0, s25, 12288
    s_mov_b32 s64, 147456
    buffer_load_dwordx4 v4, s[28:31], s64 offen nt lds
    buffer_load_dwordx4 v5, s[28:31], s64 offen offset:1024 nt lds
    buffer_load_dwordx4 v6, s[28:31], s64 offen offset:2048 nt lds
    buffer_load_dwordx4 v7, s[28:31], s64 offen offset:3072 nt lds
    v_mfma_f32_16x16x32_bf16 v[100:103], v[64:67], v[32:35], 0
    v_mfma_f32_16x16x32_bf16 v[100:103], v[68:71], v[36:39], v[100:103]
    v_mfma_f32_16x16x32_bf16 v[100:103], v[72:75], v[40:43], v[100:103]
    v_mfma_f32_16x16x32_bf16 v[100:103], v[76:79], v[44:47], v[100:103]
    v_mfma_f32_16x16x32_bf16 v[100:103], v[80:83], v[48:51], v[100:103]
    v_mfma_f32_16x16x32_bf16 v[100:103], v[84:87], v[52:55], v[100:103]
    v_mfma_f32_16x16x32_bf16 v[100:103], v[88:91], v[56:59], v[100:103]
    v_mfma_f32_16x16x32_bf16 v[100:103], v[92:95], v[60:63], v[100:103]
    s_waitcnt vmcnt(16)
    ds_read_b128 v[64:67], v8 offset:16384
    ds_read_b128 v[68:71], v9 offset:16384
    ds_read_b128 v[72:75], v10 offset:16384
    ds_read_b128 v[76:79], v11 offset:16384
    ds_read_b128 v[80:83], v8 offset:16640
    ds_read_b128 v[84:87], v9 offset:16640
    ds_read_b128 v[88:91], v10 offset:16640
    ds_read_b128 v[92:95], v11 offset:16640
    s_waitcnt lgkmcnt(0)
    s_add_u32 m0, s25, 16384
    s_mov_b32 s64, 163840
    buffer_load_dwordx4 v4, s[28:31], s64 offen nt lds
    buffer_load_dwordx4 v5, s[28:31], s64 offen offset:1024 nt lds
    buffer_load_dwordx4 v6, s[28:31], s64 offen offset:2048 nt lds
    buffer_load_dwordx4 v7, s[28:31], s64 offen offset:3072 nt lds
    s_add_u32 m0, s25, 20480
    s_mov_b32 s64, 180224
    buffer_load_dwordx4 v4, s[28:31], s64 offen nt lds
    buffer_load_dwordx4 v5, s[28:31], s64 offen offset:1024 nt lds
    buffer_load_dwordx4 v6, s[28:31], s64 offen offset:2048 nt lds
    buffer_load_dwordx4 v7, s[28:31], s64 offen offset:3072 nt lds
    v_mfma_f32_16x16x32_bf16 v[104:107], v[64:67], v[32:35], 0
    v_mfma_f32_16x16x32_bf16 v[104:107], v[68:71], v[36:39], v[104:107]
    v_mfma_f32_16x16x32_bf16 v[104:107], v[72:75], v[40:43], v[104:107]
    v_mfma_f32_16x16x32_bf16 v[104:107], v[76:79], v[44:47], v[104:107]
    v_mfma_f32_16x16x32_bf16 v[104:107], v[80:83], v[48:51], v[104:107]
    v_mfma_f32_16x16x32_bf16 v[104:107], v[84:87], v[52:55], v[104:107]
    v_mfma_f32_16x16x32_bf16 v[104:107], v[88:91], v[56:59], v[104:107]
    v_mfma_f32_16x16x32_bf16 v[104:107], v[92:95], v[60:63], v[104:107]
    s_waitcnt vmcnt(16)
    ds_read_b128 v[64:67], v8 offset:0
    ds_read_b128 v[68:71], v9 offset:0
    ds_read_b128 v[72:75], v10 offset:0
    ds_read_b128 v[76:79], v11 offset:0
    ds_read_b128 v[80:83], v8 offset:256
    ds_read_b128 v[84:87], v9 offset:256
    ds_read_b128 v[88:91], v10 offset:256
    ds_read_b128 v[92:95], v11 offset:256
    s_waitcnt lgkmcnt(0)
    s_add_u32 m0, s25, 0
    s_mov_b32 s64, 196608
    buffer_load_dwordx4 v4, s[28:31], s64 offen nt lds
    buffer_load_dwordx4 v5, s[28:31], s64 offen offset:1024 nt lds
    buffer_load_dwordx4 v6, s[28:31], s64 offen offset:2048 nt lds
    buffer_load_dwordx4 v7, s[28:31], s64 offen offset:3072 nt lds
    s_add_u32 m0, s25, 4096
    s_mov_b32 s64, 212992
    buffer_load_dwordx4 v4, s[28:31], s64 offen nt lds
    buffer_load_dwordx4 v5, s[28:31], s64 offen offset:1024 nt lds
    buffer_load_dwordx4 v6, s[28:31], s64 offen offset:2048 nt lds
    buffer_load_dwordx4 v7, s[28:31], s64 offen offset:3072 nt lds
    v_mfma_f32_16x16x32_bf16 v[108:111], v[64:67], v[32:35], 0
    v_mfma_f32_16x16x32_bf16 v[108:111], v[68:71], v[36:39], v[108:111]
    v_mfma_f32_16x16x32_bf16 v[108:111], v[72:75], v[40:43], v[108:111]
    v_mfma_f32_16x16x32_bf16 v[108:111], v[76:79], v[44:47], v[108:111]
    v_mfma_f32_16x16x32_bf16 v[108:111], v[80:83], v[48:51], v[108:111]
    v_mfma_f32_16x16x32_bf16 v[108:111], v[84:87], v[52:55], v[108:111]
    v_mfma_f32_16x16x32_bf16 v[108:111], v[88:91], v[56:59], v[108:111]
    v_mfma_f32_16x16x32_bf16 v[108:111], v[92:95], v[60:63], v[108:111]
    s_waitcnt vmcnt(16)
    ds_read_b128 v[64:67], v8 offset:8192
    ds_read_b128 v[68:71], v9 offset:8192
    ds_read_b128 v[72:75], v10 offset:8192
    ds_read_b128 v[76:79], v11 offset:8192
    ds_read_b128 v[80:83], v8 offset:8448
    ds_read_b128 v[84:87], v9 offset:8448
    ds_read_b128 v[88:91], v10 offset:8448
    ds_read_b128 v[92:95], v11 offset:8448
    s_waitcnt lgkmcnt(0)
    s_add_u32 m0, s25, 8192
    s_mov_b32 s64, 229376
    buffer_load_dwordx4 v4, s[28:31], s64 offen nt lds
    buffer_load_dwordx4 v5, s[28:31], s64 offen offset:1024 nt lds
    buffer_load_dwordx4 v6, s[28:31], s64 offen offset:2048 nt lds
    buffer_load_dwordx4 v7, s[28:31], s64 offen offset:3072 nt lds
    s_add_u32 m0, s25, 12288
    s_mov_b32 s64, 245760
    buffer_load_dwordx4 v4, s[28:31], s64 offen nt lds
    buffer_load_dwordx4 v5, s[28:31], s64 offen offset:1024 nt lds
    buffer_load_dwordx4 v6, s[28:31], s64 offen offset:2048 nt lds
    buffer_load_dwordx4 v7, s[28:31], s64 offen offset:3072 nt lds
    v_mfma_f32_16x16x32_bf16 v[112:115], v[64:67], v[32:35], 0
    v_mfma_f32_16x16x32_bf16 v[112:115], v[68:71], v[36:39], v[112:115]
    v_mfma_f32_16x16x32_bf16 v[112:115], v[72:75], v[40:43], v[112:115]
    v_mfma_f32_16x16x32_bf16 v[112:115], v[76:79], v[44:47], v[112:115]
    v_mfma_f32_16x16x32_bf16 v[112:115], v[80:83], v[48:51], v[112:115]
    v_mfma_f32_16x16x32_bf16 v[112:115], v[84:87], v[52:55], v[112:115]
    v_mfma_f32_16x16x32_bf16 v[112:115], v[88:91], v[56:59], v[112:115]
    v_mfma_f32_16x16x32_bf16 v[112:115], v[92:95], v[60:63], v[112:115]
    s_waitcnt vmcnt(16)
    ds_read_b128 v[64:67], v8 offset:16384
    ds_read_b128 v[68:71], v9 offset:16384
    ds_read_b128 v[72:75], v10 offset:16384
    ds_read_b128 v[76:79], v11 offset:16384
    ds_read_b128 v[80:83], v8 offset:16640
    ds_read_b128 v[84:87], v9 offset:16640
    ds_read_b128 v[88:91], v10 offset:16640
    ds_read_b128 v[92:95], v11 offset:16640
    s_waitcnt lgkmcnt(0)
    s_add_u32 m0, s25, 16384
    s_mov_b32 s64, 0
    buffer_load_dwordx4 v4, s[32:35], s64 offen nt lds
    buffer_load_dwordx4 v5, s[32:35], s64 offen offset:1024 nt lds
    buffer_load_dwordx4 v6, s[32:35], s64 offen offset:2048 nt lds
    buffer_load_dwordx4 v7, s[32:35], s64 offen offset:3072 nt lds
    s_add_u32 m0, s25, 20480
    s_mov_b32 s64, 16384
    buffer_load_dwordx4 v4, s[32:35], s64 offen nt lds
    buffer_load_dwordx4 v5, s[32:35], s64 offen offset:1024 nt lds
    buffer_load_dwordx4 v6, s[32:35], s64 offen offset:2048 nt lds
    buffer_load_dwordx4 v7, s[32:35], s64 offen offset:3072 nt lds
    v_mfma_f32_16x16x32_bf16 v[116:119], v[64:67], v[32:35], 0
    v_mfma_f32_16x16x32_bf16 v[116:119], v[68:71], v[36:39], v[116:119]
    v_mfma_f32_16x16x32_bf16 v[116:119], v[72:75], v[40:43], v[116:119]
    v_mfma_f32_16x16x32_bf16 v[116:119], v[76:79], v[44:47], v[116:119]
    v_mfma_f32_16x16x32_bf16 v[116:119], v[80:83], v[48:51], v[116:119]
    v_mfma_f32_16x16x32_bf16 v[116:119], v[84:87], v[52:55], v[116:119]
    v_mfma_f32_16x16x32_bf16 v[116:119], v[88:91], v[56:59], v[116:119]
    v_mfma_f32_16x16x32_bf16 v[116:119], v[92:95], v[60:63], v[116:119]
    s_waitcnt vmcnt(16)
    ds_read_b128 v[64:67], v8 offset:0
    ds_read_b128 v[68:71], v9 offset:0
    ds_read_b128 v[72:75], v10 offset:0
    ds_read_b128 v[76:79], v11 offset:0
    ds_read_b128 v[80:83], v8 offset:256
    ds_read_b128 v[84:87], v9 offset:256
    ds_read_b128 v[88:91], v10 offset:256
    ds_read_b128 v[92:95], v11 offset:256
    s_waitcnt lgkmcnt(0)
    s_add_u32 m0, s25, 0
    s_mov_b32 s64, 32768
    buffer_load_dwordx4 v4, s[32:35], s64 offen nt lds
    buffer_load_dwordx4 v5, s[32:35], s64 offen offset:1024 nt lds
    buffer_load_dwordx4 v6, s[32:35], s64 offen offset:2048 nt lds
    buffer_load_dwordx4 v7, s[32:35], s64 offen offset:3072 nt lds
    s_add_u32 m0, s25, 4096
    s_mov_b32 s64, 49152
    buffer_load_dwordx4 v4, s[32:35], s64 offen nt lds
    buffer_load_dwordx4 v5, s[32:35], s64 offen offset:1024 nt lds
    buffer_load_dwordx4 v6, s[32:35], s64 offen offset:2048 nt lds
    buffer_load_dwordx4 v7, s[32:35], s64 offen offset:3072 nt lds
    v_mfma_f32_16x16x32_bf16 v[120:123], v[64:67], v[32:35], 0
    v_mfma_f32_16x16x32_bf16 v[120:123], v[68:71], v[36:39], v[120:123]
    v_mfma_f32_16x16x32_bf16 v[120:123], v[72:75], v[40:43], v[120:123]
    v_mfma_f32_16x16x32_bf16 v[120:123], v[76:79], v[44:47], v[120:123]
    v_mfma_f32_16x16x32_bf16 v[120:123], v[80:83], v[48:51], v[120:123]
    v_mfma_f32_16x16x32_bf16 v[120:123], v[84:87], v[52:55], v[120:123]
    v_mfma_f32_16x16x32_bf16 v[120:123], v[88:91], v[56:59], v[120:123]
    v_mfma_f32_16x16x32_bf16 v[120:123], v[92:95], v[60:63], v[120:123]
    s_waitcnt vmcnt(16)
    ds_read_b128 v[64:67], v8 offset:8192
    ds_read_b128 v[68:71], v9 offset:8192
    ds_read_b128 v[72:75], v10 offset:8192
    ds_read_b128 v[76:79], v11 offset:8192
    ds_read_b128 v[80:83], v8 offset:8448
    ds_read_b128 v[84:87], v9 offset:8448
    ds_read_b128 v[88:91], v10 offset:8448
    ds_read_b128 v[92:95], v11 offset:8448
    s_waitcnt lgkmcnt(0)
    s_add_u32 m0, s25, 8192
    s_mov_b32 s64, 65536
    buffer_load_dwordx4 v4, s[32:35], s64 offen nt lds
    buffer_load_dwordx4 v5, s[32:35], s64 offen offset:1024 nt lds
    buffer_load_dwordx4 v6, s[32:35], s64 offen offset:2048 nt lds
    buffer_load_dwordx4 v7, s[32:35], s64 offen offset:3072 nt lds
    s_add_u32 m0, s25, 12288
    s_mov_b32 s64, 81920
    buffer_load_dwordx4 v4, s[32:35], s64 offen nt lds
    buffer_load_dwordx4 v5, s[32:35], s64 offen offset:1024 nt lds
    buffer_load_dwordx4 v6, s[32:35], s64 offen offset:2048 nt lds
    buffer_load_dwordx4 v7, s[32:35], s64 offen offset:3072 nt lds
    v_mfma_f32_16x16x32_bf16 v[124:127], v[64:67], v[32:35], 0
    v_mfma_f32_16x16x32_bf16 v[124:127], v[68:71], v[36:39], v[124:127]
    v_mfma_f32_16x16x32_bf16 v[124:127], v[72:75], v[40:43], v[124:127]
    v_mfma_f32_16x16x32_bf16 v[124:127], v[76:79], v[44:47], v[124:127]
    v_mfma_f32_16x16x32_bf16 v[124:127], v[80:83], v[48:51], v[124:127]
    v_mfma_f32_16x16x32_bf16 v[124:127], v[84:87], v[52:55], v[124:127]
    v_mfma_f32_16x16x32_bf16 v[124:127], v[88:91], v[56:59], v[124:127]
    v_mfma_f32_16x16x32_bf16 v[124:127], v[92:95], v[60:63], v[124:127]
    s_nop 7
    v_max3_f32 v208, v96, v97, v216
    v_max3_f32 v208, v98, v99, v208
    v_max3_f32 v208, v100, v101, v208
    v_max3_f32 v208, v102, v103, v208
    v_max3_f32 v208, v104, v105, v208
    v_max3_f32 v208, v106, v107, v208
    v_max3_f32 v208, v108, v109, v208
    v_max3_f32 v208, v110, v111, v208
    v_max3_f32 v208, v112, v113, v208
    v_max3_f32 v208, v114, v115, v208
    v_max3_f32 v208, v116, v117, v208
    v_max3_f32 v208, v118, v119, v208
    v_max3_f32 v208, v120, v121, v208
    v_max3_f32 v208, v122, v123, v208
    v_max3_f32 v208, v124, v125, v208
    v_max3_f32 v208, v126, v127, v208
    v_mov_b32 v20, v208
    s_nop 1
    v_permlane16_swap_b32 v20, v208
    s_nop 1
    v_max_f32 v208, v208, v20
    v_mov_b32 v20, v208
    s_nop 1
    v_permlane32_swap_b32 v20, v208
    s_nop 1
    v_max_f32 v208, v208, v20
    v_mul_f32 v208, s75, v208
    v_fma_f32 v96, v96, s75, -v208
    v_fma_f32 v97, v97, s75, -v208
    v_fma_f32 v98, v98, s75, -v208
    v_fma_f32 v99, v99, s75, -v208
    v_fma_f32 v100, v100, s75, -v208
    v_fma_f32 v101, v101, s75, -v208
    v_fma_f32 v102, v102, s75, -v208
    v_fma_f32 v103, v103, s75, -v208
    v_fma_f32 v104, v104, s75, -v208
    v_fma_f32 v105, v105, s75, -v208
    v_fma_f32 v106, v106, s75, -v208
    v_fma_f32 v107, v107, s75, -v208
    v_fma_f32 v108, v108, s75, -v208
    v_fma_f32 v109, v109, s75, -v208
    v_fma_f32 v110, v110, s75, -v208
    v_fma_f32 v111, v111, s75, -v208
    v_fma_f32 v112, v112, s75, -v208
    v_fma_f32 v113, v113, s75, -v208
    v_fma_f32 v114, v114, s75, -v208
    v_fma_f32 v115, v115, s75, -v208
    v_fma_f32 v116, v116, s75, -v208
    v_fma_f32 v117, v117, s75, -v208
    v_fma_f32 v118, v118, s75, -v208
    v_fma_f32 v119, v119, s75, -v208
    v_fma_f32 v120, v120, s75, -v208
    v_fma_f32 v121, v121, s75, -v208
    v_fma_f32 v122, v122, s75, -v208
    v_fma_f32 v123, v123, s75, -v208
    v_fma_f32 v124, v124, s75, -v208
    v_fma_f32 v125, v125, s75, -v208
    v_fma_f32 v126, v126, s75, -v208
    v_fma_f32 v127, v127, s75, -v208
    v_fma_f32 v210, v216, s75, -v208
    v_exp_f32 v96, v96
    v_exp_f32 v97, v97
    v_exp_f32 v98, v98
    v_exp_f32 v99, v99
    v_exp_f32 v100, v100
    v_exp_f32 v101, v101
    v_exp_f32 v102, v102
    v_exp_f32 v103, v103
    v_exp_f32 v104, v104
    v_exp_f32 v105, v105
    v_exp_f32 v106, v106
    v_exp_f32 v107, v107
    v_exp_f32 v108, v108
    v_exp_f32 v109, v109
    v_exp_f32 v110, v110
    v_exp_f32 v111, v111
    v_exp_f32 v112, v112
    v_exp_f32 v113, v113
    v_exp_f32 v114, v114
    v_exp_f32 v115, v115
    v_exp_f32 v116, v116
    v_exp_f32 v117, v117
    v_exp_f32 v118, v118
    v_exp_f32 v119, v119
    v_exp_f32 v120, v120
    v_exp_f32 v121, v121
    v_exp_f32 v122, v122
    v_exp_f32 v123, v123
    v_exp_f32 v124, v124
    v_exp_f32 v125, v125
    v_exp_f32 v126, v126
    v_exp_f32 v127, v127
    v_exp_f32 v210, v210
    v_add_f32 v209, v96, v97
    v_add_f32 v209, v209, v98
    v_add_f32 v209, v209, v99
    v_add_f32 v209, v209, v100
    v_add_f32 v209, v209, v101
    v_add_f32 v209, v209, v102
    v_add_f32 v209, v209, v103
    v_add_f32 v209, v209, v104
    v_add_f32 v209, v209, v105
    v_add_f32 v209, v209, v106
    v_add_f32 v209, v209, v107
    v_add_f32 v209, v209, v108
    v_add_f32 v209, v209, v109
    v_add_f32 v209, v209, v110
    v_add_f32 v209, v209, v111
    v_add_f32 v209, v209, v112
    v_add_f32 v209, v209, v113
    v_add_f32 v209, v209, v114
    v_add_f32 v209, v209, v115
    v_add_f32 v209, v209, v116
    v_add_f32 v209, v209, v117
    v_add_f32 v209, v209, v118
    v_add_f32 v209, v209, v119
    v_add_f32 v209, v209, v120
    v_add_f32 v209, v209, v121
    v_add_f32 v209, v209, v122
    v_add_f32 v209, v209, v123
    v_add_f32 v209, v209, v124
    v_add_f32 v209, v209, v125
    v_add_f32 v209, v209, v126
    v_add_f32 v209, v209, v127
    v_mov_b32 v20, v209
    s_nop 1
    v_permlane16_swap_b32 v20, v209
    s_nop 1
    v_add_f32 v209, v209, v20
    v_mov_b32 v20, v209
    s_nop 1
    v_permlane32_swap_b32 v20, v209
    s_nop 1
    v_add_f32 v209, v209, v20
    v_add_f32 v209, v209, v210
    v_lshlrev_b32 v20, 3, v1
    s_lshl_b32 s65, s24, 4
    s_add_u32 s65, s65, 98304
    v_add_u32 v20, s65, v20
    v_mov_b32 v22, v208
    v_mov_b32 v23, v209
    s_mov_b64 exec, 3
    ds_write_b64 v20, v[22:23]
    s_mov_b64 exec, 1
    v_mov_b32 v24, 98432
    v_mov_b32 v25, 1
    ds_add_u32 v24, v25
    s_mov_b64 exec, -1
    s_mov_b64 exec, s[66:67]
    v_cvt_pk_bf16_f32 v128, v96, v97
    v_cvt_pk_bf16_f32 v129, v98, v99
    v_cvt_pk_bf16_f32 v130, v100, v101
    v_cvt_pk_bf16_f32 v131, v102, v103
    v_cvt_pk_bf16_f32 v132, v104, v105
    v_cvt_pk_bf16_f32 v133, v106, v107
    v_cvt_pk_bf16_f32 v134, v108, v109
    v_cvt_pk_bf16_f32 v135, v110, v111
    v_cvt_pk_bf16_f32 v136, v112, v113
    v_cvt_pk_bf16_f32 v137, v114, v115
    v_cvt_pk_bf16_f32 v138, v116, v117
    v_cvt_pk_bf16_f32 v139, v118, v119
    v_cvt_pk_bf16_f32 v140, v120, v121
    v_cvt_pk_bf16_f32 v141, v122, v123
    v_cvt_pk_bf16_f32 v142, v124, v125
    v_cvt_pk_bf16_f32 v143, v126, v127
    s_mov_b64 exec, s[68:69]
    v_cvt_pk_bf16_f32 v144, v96, v97
    v_cvt_pk_bf16_f32 v145, v98, v99
    v_cvt_pk_bf16_f32 v146, v100, v101
    v_cvt_pk_bf16_f32 v147, v102, v103
    v_cvt_pk_bf16_f32 v148, v104, v105
    v_cvt_pk_bf16_f32 v149, v106, v107
    v_cvt_pk_bf16_f32 v150, v108, v109
    v_cvt_pk_bf16_f32 v151, v110, v111
    v_cvt_pk_bf16_f32 v152, v112, v113
    v_cvt_pk_bf16_f32 v153, v114, v115
    v_cvt_pk_bf16_f32 v154, v116, v117
    v_cvt_pk_bf16_f32 v155, v118, v119
    v_cvt_pk_bf16_f32 v156, v120, v121
    v_cvt_pk_bf16_f32 v157, v122, v123
    v_cvt_pk_bf16_f32 v158, v124, v125
    v_cvt_pk_bf16_f32 v159, v126, v127
    s_mov_b64 exec, s[70:71]
    v_cvt_pk_bf16_f32 v160, v96, v97
    v_cvt_pk_bf16_f32 v161, v98, v99
    v_cvt_pk_bf16_f32 v162, v100, v101
    v_cvt_pk_bf16_f32 v163, v102, v103
    v_cvt_pk_bf16_f32 v164, v104, v105
    v_cvt_pk_bf16_f32 v165, v106, v107
    v_cvt_pk_bf16_f32 v166, v108, v109
    v_cvt_pk_bf16_f32 v167, v110, v111
    v_cvt_pk_bf16_f32 v168, v112, v113
    v_cvt_pk_bf16_f32 v169, v114, v115
    v_cvt_pk_bf16_f32 v170, v116, v117
    v_cvt_pk_bf16_f32 v171, v118, v119
    v_cvt_pk_bf16_f32 v172, v120, v121
    v_cvt_pk_bf16_f32 v173, v122, v123
    v_cvt_pk_bf16_f32 v174, v124, v125
    v_cvt_pk_bf16_f32 v175, v126, v127
    s_mov_b64 exec, s[72:73]
    v_cvt_pk_bf16_f32 v176, v96, v97
    v_cvt_pk_bf16_f32 v177, v98, v99
    v_cvt_pk_bf16_f32 v178, v100, v101
    v_cvt_pk_bf16_f32 v179, v102, v103
    v_cvt_pk_bf16_f32 v180, v104, v105
    v_cvt_pk_bf16_f32 v181, v106, v107
    v_cvt_pk_bf16_f32 v182, v108, v109
    v_cvt_pk_bf16_f32 v183, v110, v111
    v_cvt_pk_bf16_f32 v184, v112, v113
    v_cvt_pk_bf16_f32 v185, v114, v115
    v_cvt_pk_bf16_f32 v186, v116, v117
    v_cvt_pk_bf16_f32 v187, v118, v119
    v_cvt_pk_bf16_f32 v188, v120, v121
    v_cvt_pk_bf16_f32 v189, v122, v123
    v_cvt_pk_bf16_f32 v190, v124, v125
    v_cvt_pk_bf16_f32 v191, v126, v127
    s_mov_b64 exec, -1
    s_cmp_lg_u32 s74, 0
    s_cbranch_scc1 L_notree2
    v_mov_b32_dpp v20, v210 quad_perm:[0,0,2,2] row_mask:0xf bank_mask:0xf
    v_mov_b32_dpp v21, v210 quad_perm:[1,1,3,3] row_mask:0xf bank_mask:0xf
    v_mul_f32 v192, v20, v212
    v_mul_f32 v193, v21, v212
    v_mul_f32 v196, v20, v213
    v_mul_f32 v197, v21, v213
    v_mul_f32 v200, v20, v214
    v_mul_f32 v201, v21, v214
    v_mul_f32 v204, v20, v215
    v_mul_f32 v205, v21, v215
L_notree2:
    s_waitcnt vmcnt(16)
    ds_read_b64_tr_b16 v[32:33], v12 offset:16384
    ds_read_b64_tr_b16 v[36:37], v13 offset:16384
    ds_read_b64_tr_b16 v[40:41], v14 offset:16384
    ds_read_b64_tr_b16 v[44:45], v15 offset:16384
    ds_read_b64_tr_b16 v[48:49], v16 offset:16384
    ds_read_b64_tr_b16 v[52:53], v17 offset:16384
    ds_read_b64_tr_b16 v[56:57], v18 offset:16384
    ds_read_b64_tr_b16 v[60:61], v19 offset:16384
    ds_read_b64_tr_b16 v[64:65], v12 offset:16640
    ds_read_b64_tr_b16 v[68:69], v13 offset:16640
    ds_read_b64_tr_b16 v[72:73], v14 offset:16640
    ds_read_b64_tr_b16 v[76:77], v15 offset:16640
    ds_read_b64_tr_b16 v[80:81], v16 offset:16640
    ds_read_b64_tr_b16 v[84:85], v17 offset:16640
    ds_read_b64_tr_b16 v[88:89], v18 offset:16640
    ds_read_b64_tr_b16 v[92:93], v19 offset:16640
    s_waitcnt lgkmcnt(0)
    s_add_u32 m0, s25, 16384
    s_mov_b32 s64, 98304
    buffer_load_dwordx4 v4, s[32:35], s64 offen nt lds
    buffer_load_dwordx4 v5, s[32:35], s64 offen offset:1024 nt lds
    buffer_load_dwordx4 v6, s[32:35], s64 offen offset:2048 nt lds
    buffer_load_dwordx4 v7, s[32:35], s64 offen offset:3072 nt lds
    s_add_u32 m0, s25, 20480
    s_mov_b32 s64, 114688
    buffer_load_dwordx4 v4, s[32:35], s64 offen nt lds
    buffer_load_dwordx4 v5, s[32:35], s64 offen offset:1024 nt lds
    buffer_load_dwordx4 v6, s[32:35], s64 offen offset:2048 nt lds
    buffer_load_dwordx4 v7, s[32:35], s64 offen offset:3072 nt lds
    s_waitcnt vmcnt(16)
    ds_read_b64_tr_b16 v[34:35], v12 offset:0
    ds_read_b64_tr_b16 v[38:39], v13 offset:0
    ds_read_b64_tr_b16 v[42:43], v14 offset:0
    ds_read_b64_tr_b16 v[46:47], v15 offset:0
    ds_read_b64_tr_b16 v[50:51], v16 offset:0
    ds_read_b64_tr_b16 v[54:55], v17 offset:0
    ds_read_b64_tr_b16 v[58:59], v18 offset:0
    ds_read_b64_tr_b16 v[62:63], v19 offset:0
    ds_read_b64_tr_b16 v[66:67], v12 offset:256
    ds_read_b64_tr_b16 v[70:71], v13 offset:256
    ds_read_b64_tr_b16 v[74:75], v14 offset:256
    ds_read_b64_tr_b16 v[78:79], v15 offset:256
    ds_read_b64_tr_b16 v[82:83], v16 offset:256
    ds_read_b64_tr_b16 v[86:87], v17 offset:256
    ds_read_b64_tr_b16 v[90:91], v18 offset:256
    ds_read_b64_tr_b16 v[94:95], v19 offset:256
    s_waitcnt lgkmcnt(0)
    s_add_u32 m0, s25, 0
    s_mov_b32 s64, 131072
    buffer_load_dwordx4 v4, s[32:35], s64 offen nt lds
    buffer_load_dwordx4 v5, s[32:35], s64 offen offset:1024 nt lds
    buffer_load_dwordx4 v6, s[32:35], s64 offen offset:2048 nt lds
    buffer_load_dwordx4 v7, s[32:35], s64 offen offset:3072 nt lds
    s_add_u32 m0, s25, 4096
    s_mov_b32 s64, 147456
    buffer_load_dwordx4 v4, s[32:35], s64 offen nt lds
    buffer_load_dwordx4 v5, s[32:35], s64 offen offset:1024 nt lds
    buffer_load_dwordx4 v6, s[32:35], s64 offen offset:2048 nt lds
    buffer_load_dwordx4 v7, s[32:35], s64 offen offset:3072 nt lds
    v_mfma_f32_16x16x32_bf16 v[192:195], v[128:131], v[32:35], v[192:195]
    v_mfma_f32_16x16x32_bf16 v[192:195], v[144:147], v[36:39], v[192:195]
    v_mfma_f32_16x16x32_bf16 v[192:195], v[160:163], v[40:43], v[192:195]
    v_mfma_f32_16x16x32_bf16 v[192:195], v[176:179], v[44:47], v[192:195]
    v_mfma_f32_16x16x32_bf16 v[196:199], v[128:131], v[48:51], v[196:199]
    v_mfma_f32_16x16x32_bf16 v[196:199], v[144:147], v[52:55], v[196:199]
    v_mfma_f32_16x16x32_bf16 v[196:199], v[160:163], v[56:59], v[196:199]
    v_mfma_f32_16x16x32_bf16 v[196:199], v[176:179], v[60:63], v[196:199]
    v_mfma_f32_16x16x32_bf16 v[200:203], v[128:131], v[64:67], v[200:203]
    v_mfma_f32_16x16x32_bf16 v[200:203], v[144:147], v[68:71], v[200:203]
    v_mfma_f32_16x16x32_bf16 v[200:203], v[160:163], v[72:75], v[200:203]
    v_mfma_f32_16x16x32_bf16 v[200:203], v[176:179], v[76:79], v[200:203]
    v_mfma_f32_16x16x32_bf16 v[204:207], v[128:131], v[80:83], v[204:207]
    v_mfma_f32_16x16x32_bf16 v[204:207], v[144:147], v[84:87], v[204:207]
    v_mfma_f32_16x16x32_bf16 v[204:207], v[160:163], v[88:91], v[204:207]
    v_mfma_f32_16x16x32_bf16 v[204:207], v[176:179], v[92:95], v[204:207]
    s_waitcnt vmcnt(16)
    ds_read_b64_tr_b16 v[32:33], v12 offset:8192
    ds_read_b64_tr_b16 v[36:37], v13 offset:8192
    ds_read_b64_tr_b16 v[40:41], v14 offset:8192
    ds_read_b64_tr_b16 v[44:45], v15 offset:8192
    ds_read_b64_tr_b16 v[48:49], v16 offset:8192
    ds_read_b64_tr_b16 v[52:53], v17 offset:8192
    ds_read_b64_tr_b16 v[56:57], v18 offset:8192
    ds_read_b64_tr_b16 v[60:61], v19 offset:8192
    ds_read_b64_tr_b16 v[64:65], v12 offset:8448
    ds_read_b64_tr_b16 v[68:69], v13 offset:8448
    ds_read_b64_tr_b16 v[72:73], v14 offset:8448
    ds_read_b64_tr_b16 v[76:77], v15 offset:8448
    ds_read_b64_tr_b16 v[80:81], v16 offset:8448
    ds_read_b64_tr_b16 v[84:85], v17 offset:8448
    ds_read_b64_tr_b16 v[88:89], v18 offset:8448
    ds_read_b64_tr_b16 v[92:93], v19 offset:8448
    s_waitcnt lgkmcnt(0)
    s_add_u32 m0, s25, 8192
    s_mov_b32 s64, 163840
    buffer_load_dwordx4 v4, s[32:35], s64 offen nt lds
    buffer_load_dwordx4 v5, s[32:35], s64 offen offset:1024 nt lds
    buffer_load_dwordx4 v6, s[32:35], s64 offen offset:2048 nt lds
    buffer_load_dwordx4 v7, s[32:35], s64 offen offset:3072 nt lds
    s_add_u32 m0, s25, 12288
    s_mov_b32 s64, 180224
    buffer_load_dwordx4 v4, s[32:35], s64 offen nt lds
    buffer_load_dwordx4 v5, s[32:35], s64 offen offset:1024 nt lds
    buffer_load_dwordx4 v6, s[32:35], s64 offen offset:2048 nt lds
    buffer_load_dwordx4 v7, s[32:35], s64 offen offset:3072 nt lds
    s_waitcnt vmcnt(16)
    ds_read_b64_tr_b16 v[34:35], v12 offset:16384
    ds_read_b64_tr_b16 v[38:39], v13 offset:16384
    ds_read_b64_tr_b16 v[42:43], v14 offset:16384
    ds_read_b64_tr_b16 v[46:47], v15 offset:16384
    ds_read_b64_tr_b16 v[50:51], v16 offset:16384
    ds_read_b64_tr_b16 v[54:55], v17 offset:16384
    ds_read_b64_tr_b16 v[58:59], v18 offset:16384
    ds_read_b64_tr_b16 v[62:63], v19 offset:16384
    ds_read_b64_tr_b16 v[66:67], v12 offset:16640
    ds_read_b64_tr_b16 v[70:71], v13 offset:16640
    ds_read_b64_tr_b16 v[74:75], v14 offset:16640
    ds_read_b64_tr_b16 v[78:79], v15 offset:16640
    ds_read_b64_tr_b16 v[82:83], v16 offset:16640
    ds_read_b64_tr_b16 v[86:87], v17 offset:16640
    ds_read_b64_tr_b16 v[90:91], v18 offset:16640
    ds_read_b64_tr_b16 v[94:95], v19 offset:16640
    s_waitcnt lgkmcnt(0)
    s_add_u32 m0, s25, 16384
    s_mov_b32 s64, 196608
    buffer_load_dwordx4 v4, s[32:35], s64 offen nt lds
    buffer_load_dwordx4 v5, s[32:35], s64 offen offset:1024 nt lds
    buffer_load_dwordx4 v6, s[32:35], s64 offen offset:2048 nt lds
    buffer_load_dwordx4 v7, s[32:35], s64 offen offset:3072 nt lds
    s_add_u32 m0, s25, 20480
    s_mov_b32 s64, 212992
    buffer_load_dwordx4 v4, s[32:35], s64 offen nt lds
    buffer_load_dwordx4 v5, s[32:35], s64 offen offset:1024 nt lds
    buffer_load_dwordx4 v6, s[32:35], s64 offen offset:2048 nt lds
    buffer_load_dwordx4 v7, s[32:35], s64 offen offset:3072 nt lds
    v_mfma_f32_16x16x32_bf16 v[192:195], v[132:135], v[32:35], v[192:195]
    v_mfma_f32_16x16x32_bf16 v[192:195], v[148:151], v[36:39], v[192:195]
    v_mfma_f32_16x16x32_bf16 v[192:195], v[164:167], v[40:43], v[192:195]
    v_mfma_f32_16x16x32_bf16 v[192:195], v[180:183], v[44:47], v[192:195]
    v_mfma_f32_16x16x32_bf16 v[196:199], v[132:135], v[48:51], v[196:199]
    v_mfma_f32_16x16x32_bf16 v[196:199], v[148:151], v[52:55], v[196:199]
    v_mfma_f32_16x16x32_bf16 v[196:199], v[164:167], v[56:59], v[196:199]
    v_mfma_f32_16x16x32_bf16 v[196:199], v[180:183], v[60:63], v[196:199]
    v_mfma_f32_16x16x32_bf16 v[200:203], v[132:135], v[64:67], v[200:203]
    v_mfma_f32_16x16x32_bf16 v[200:203], v[148:151], v[68:71], v[200:203]
    v_mfma_f32_16x16x32_bf16 v[200:203], v[164:167], v[72:75], v[200:203]
    v_mfma_f32_16x16x32_bf16 v[200:203], v[180:183], v[76:79], v[200:203]
    v_mfma_f32_16x16x32_bf16 v[204:207], v[132:135], v[80:83], v[204:207]
    v_mfma_f32_16x16x32_bf16 v[204:207], v[148:151], v[84:87], v[204:207]
    v_mfma_f32_16x16x32_bf16 v[204:207], v[164:167], v[88:91], v[204:207]
    v_mfma_f32_16x16x32_bf16 v[204:207], v[180:183], v[92:95], v[204:207]
    s_waitcnt vmcnt(16)
    ds_read_b64_tr_b16 v[32:33], v12 offset:0
    ds_read_b64_tr_b16 v[36:37], v13 offset:0
    ds_read_b64_tr_b16 v[40:41], v14 offset:0
    ds_read_b64_tr_b16 v[44:45], v15 offset:0
    ds_read_b64_tr_b16 v[48:49], v16 offset:0
    ds_read_b64_tr_b16 v[52:53], v17 offset:0
    ds_read_b64_tr_b16 v[56:57], v18 offset:0
    ds_read_b64_tr_b16 v[60:61], v19 offset:0
    ds_read_b64_tr_b16 v[64:65], v12 offset:256
    ds_read_b64_tr_b16 v[68:69], v13 offset:256
    ds_read_b64_tr_b16 v[72:73], v14 offset:256
    ds_read_b64_tr_b16 v[76:77], v15 offset:256
    ds_read_b64_tr_b16 v[80:81], v16 offset:256
    ds_read_b64_tr_b16 v[84:85], v17 offset:256
    ds_read_b64_tr_b16 v[88:89], v18 offset:256
    ds_read_b64_tr_b16 v[92:93], v19 offset:256
    s_waitcnt lgkmcnt(0)
    s_add_u32 m0, s25, 0
    s_mov_b32 s64, 229376
    buffer_load_dwordx4 v4, s[32:35], s64 offen nt lds
    buffer_load_dwordx4 v5, s[32:35], s64 offen offset:1024 nt lds
    buffer_load_dwordx4 v6, s[32:35], s64 offen offset:2048 nt lds
    buffer_load_dwordx4 v7, s[32:35], s64 offen offset:3072 nt lds
    s_add_u32 m0, s25, 4096
    s_mov_b32 s64, 245760
    buffer_load_dwordx4 v4, s[32:35], s64 offen nt lds
    buffer_load_dwordx4 v5, s[32:35], s64 offen offset:1024 nt lds
    buffer_load_dwordx4 v6, s[32:35], s64 offen offset:2048 nt lds
    buffer_load_dwordx4 v7, s[32:35], s64 offen offset:3072 nt lds
    s_waitcnt vmcnt(16)
    ds_read_b64_tr_b16 v[34:35], v12 offset:8192
    ds_read_b64_tr_b16 v[38:39], v13 offset:8192
    ds_read_b64_tr_b16 v[42:43], v14 offset:8192
    ds_read_b64_tr_b16 v[46:47], v15 offset:8192
    ds_read_b64_tr_b16 v[50:51], v16 offset:8192
    ds_read_b64_tr_b16 v[54:55], v17 offset:8192
    ds_read_b64_tr_b16 v[58:59], v18 offset:8192
    ds_read_b64_tr_b16 v[62:63], v19 offset:8192
    ds_read_b64_tr_b16 v[66:67], v12 offset:8448
    ds_read_b64_tr_b16 v[70:71], v13 offset:8448
    ds_read_b64_tr_b16 v[74:75], v14 offset:8448
    ds_read_b64_tr_b16 v[78:79], v15 offset:8448
    ds_read_b64_tr_b16 v[82:83], v16 offset:8448
    ds_read_b64_tr_b16 v[86:87], v17 offset:8448
    ds_read_b64_tr_b16 v[90:91], v18 offset:8448
    ds_read_b64_tr_b16 v[94:95], v19 offset:8448
    s_waitcnt lgkmcnt(0)
    v_mfma_f32_16x16x32_bf16 v[192:195], v[136:139], v[32:35], v[192:195]
    v_mfma_f32_16x16x32_bf16 v[192:195], v[152:155], v[36:39], v[192:195]
    v_mfma_f32_16x16x32_bf16 v[192:195], v[168:171], v[40:43], v[192:195]
    v_mfma_f32_16x16x32_bf16 v[192:195], v[184:187], v[44:47], v[192:195]
    v_mfma_f32_16x16x32_bf16 v[196:199], v[136:139], v[48:51], v[196:199]
    v_mfma_f32_16x16x32_bf16 v[196:199], v[152:155], v[52:55], v[196:199]
    v_mfma_f32_16x16x32_bf16 v[196:199], v[168:171], v[56:59], v[196:199]
    v_mfma_f32_16x16x32_bf16 v[196:199], v[184:187], v[60:63], v[196:199]
    v_mfma_f32_16x16x32_bf16 v[200:203], v[136:139], v[64:67], v[200:203]
    v_mfma_f32_16x16x32_bf16 v[200:203], v[152:155], v[68:71], v[200:203]
    v_mfma_f32_16x16x32_bf16 v[200:203], v[168:171], v[72:75], v[200:203]
    v_mfma_f32_16x16x32_bf16 v[200:203], v[184:187], v[76:79], v[200:203]
    v_mfma_f32_16x16x32_bf16 v[204:207], v[136:139], v[80:83], v[204:207]
    v_mfma_f32_16x16x32_bf16 v[204:207], v[152:155], v[84:87], v[204:207]
    v_mfma_f32_16x16x32_bf16 v[204:207], v[168:171], v[88:91], v[204:207]
    v_mfma_f32_16x16x32_bf16 v[204:207], v[184:187], v[92:95], v[204:207]
    s_waitcnt vmcnt(8)
    ds_read_b64_tr_b16 v[32:33], v12 offset:16384
    ds_read_b64_tr_b16 v[36:37], v13 offset:16384
    ds_read_b64_tr_b16 v[40:41], v14 offset:16384
    ds_read_b64_tr_b16 v[44:45], v15 offset:16384
    ds_read_b64_tr_b16 v[48:49], v16 offset:16384
    ds_read_b64_tr_b16 v[52:53], v17 offset:16384
    ds_read_b64_tr_b16 v[56:57], v18 offset:16384
    ds_read_b64_tr_b16 v[60:61], v19 offset:16384
    ds_read_b64_tr_b16 v[64:65], v12 offset:16640
    ds_read_b64_tr_b16 v[68:69], v13 offset:16640
    ds_read_b64_tr_b16 v[72:73], v14 offset:16640
    ds_read_b64_tr_b16 v[76:77], v15 offset:16640
    ds_read_b64_tr_b16 v[80:81], v16 offset:16640
    ds_read_b64_tr_b16 v[84:85], v17 offset:16640
    ds_read_b64_tr_b16 v[88:89], v18 offset:16640
    ds_read_b64_tr_b16 v[92:93], v19 offset:16640
    s_waitcnt lgkmcnt(0)
    s_waitcnt vmcnt(0)
    ds_read_b64_tr_b16 v[34:35], v12 offset:0
    ds_read_b64_tr_b16 v[38:39], v13 offset:0
    ds_read_b64_tr_b16 v[42:43], v14 offset:0
    ds_read_b64_tr_b16 v[46:47], v15 offset:0
    ds_read_b64_tr_b16 v[50:51], v16 offset:0
    ds_read_b64_tr_b16 v[54:55], v17 offset:0
    ds_read_b64_tr_b16 v[58:59], v18 offset:0
    s_waitcnt lgkmcnt(6)
    v_mfma_f32_16x16x32_bf16 v[192:195], v[140:143], v[32:35], v[192:195]
    ds_read_b64_tr_b16 v[62:63], v19 offset:0
    s_waitcnt lgkmcnt(6)
    v_mfma_f32_16x16x32_bf16 v[192:195], v[156:159], v[36:39], v[192:195]
    ds_read_b64_tr_b16 v[66:67], v12 offset:256
    s_waitcnt lgkmcnt(6)
    v_mfma_f32_16x16x32_bf16 v[192:195], v[172:175], v[40:43], v[192:195]
    ds_read_b64_tr_b16 v[70:71], v13 offset:256
    s_waitcnt lgkmcnt(6)
    v_mfma_f32_16x16x32_bf16 v[192:195], v[188:191], v[44:47], v[192:195]
    ds_read_b64_tr_b16 v[74:75], v14 offset:256
    s_waitcnt lgkmcnt(6)
    v_mfma_f32_16x16x32_bf16 v[196:199], v[140:143], v[48:51], v[196:199]
    ds_read_b64_tr_b16 v[78:79], v15 offset:256
    s_waitcnt lgkmcnt(6)
    v_mfma_f32_16x16x32_bf16 v[196:199], v[156:159], v[52:55], v[196:199]
    ds_read_b64_tr_b16 v[82:83], v16 offset:256
    s_waitcnt lgkmcnt(6)
    v_mfma_f32_16x16x32_bf16 v[196:199], v[172:175], v[56:59], v[196:199]
    s_nop 1
    ds_write_b64 v220, v[192:193] offset:8192
    ds_read_b64_tr_b16 v[86:87], v17 offset:256
    s_waitcnt lgkmcnt(7)
    v_mfma_f32_16x16x32_bf16 v[196:199], v[188:191], v[60:63], v[196:199]
    ds_read_b64_tr_b16 v[90:91], v18 offset:256
    s_waitcnt lgkmcnt(7)
    v_mfma_f32_16x16x32_bf16 v[200:203], v[140:143], v[64:67], v[200:203]
    ds_read_b64_tr_b16 v[94:95], v19 offset:256
    s_waitcnt lgkmcnt(7)
    v_mfma_f32_16x16x32_bf16 v[200:203], v[156:159], v[68:71], v[200:203]
    s_waitcnt lgkmcnt(6)
    v_mfma_f32_16x16x32_bf16 v[200:203], v[172:175], v[72:75], v[200:203]
    s_nop 1
    ds_write_b64 v220, v[196:197] offset:8704
    s_waitcnt lgkmcnt(6)
    v_mfma_f32_16x16x32_bf16 v[200:203], v[188:191], v[76:79], v[200:203]
    s_waitcnt lgkmcnt(5)
    v_mfma_f32_16x16x32_bf16 v[204:207], v[140:143], v[80:83], v[204:207]
    s_waitcnt lgkmcnt(3)
    v_mfma_f32_16x16x32_bf16 v[204:207], v[156:159], v[84:87], v[204:207]
    s_waitcnt lgkmcnt(2)
    v_mfma_f32_16x16x32_bf16 v[204:207], v[172:175], v[88:91], v[204:207]
    s_nop 1
    ds_write_b64 v220, v[200:201] offset:9216
    s_waitcnt lgkmcnt(2)
    v_mfma_f32_16x16x32_bf16 v[204:207], v[188:191], v[92:95], v[204:207]
    v_mov_b32 v21, 98368
    s_nop 6
    ds_write_b64 v220, v[204:205] offset:9728
    s_waitcnt lgkmcnt(0)
    s_barrier
    ds_read_b32 v22, v21 offset:32
    ds_read_b128 v[40:43], v21
    ds_read_b128 v[44:47], v21 offset:16
    ds_read_b64 v[32:33], v217 offset:8192
    ds_read_b64 v[34:35], v217 offset:32768
    ds_read_b64 v[36:37], v218 offset:8192
    ds_read_b64 v[38:39], v218 offset:32768
    s_waitcnt lgkmcnt(6)
    v_readfirstlane_b32 s65, v22
    s_waitcnt lgkmcnt(3)
    v_mul_f32 v28, v40, v32
    v_mul_f32 v29, v41, v33
    s_waitcnt lgkmcnt(2)
    v_fmac_f32 v28, v42, v34
    v_fmac_f32 v29, v43, v35
    s_waitcnt lgkmcnt(1)
    v_fmac_f32 v28, v44, v36
    v_fmac_f32 v29, v45, v37
    s_waitcnt lgkmcnt(0)
    v_fmac_f32 v28, v46, v38
    v_fmac_f32 v29, v47, v39
    v_and_or_b32 v28, v28, -2, v222
    v_and_or_b32 v29, v29, -2, v223
    s_cmp_eq_u32 s65, 0
    s_cbranch_scc1 L_msg_far
    buffer_store_dwordx2 v[28:29], v219, s[52:55], s79 offen
    s_branch L_end
L_msg_far:
    buffer_store_dwordx2 v[28:29], v219, s[52:55], s79 offen sc0 sc1
    s_branch L_end
L_helper:
    s_setprio 3
    v_mov_b32 v12, 98304
    v_mov_b32 v13, 0
    ds_write_b32 v12, v13 offset:128
    v_and_b32 v6, 3, v1
    v_lshlrev_b32 v6, 4, v6
    v_lshrrev_b32 v7, 2, v1
    v_lshl_add_u32 v6, v7, 6, v6
    v_lshlrev_b32 v14, 4, v7
    s_lshl_b32 s76, s22, 16
    s_lshl_b32 s77, s23, 11
    s_add_u32 s64, s76, s77
    s_lshl_b32 s65, s22, 5
    s_add_u32 s65, s65, s23
    s_lshl_b32 s65, s65, 4
    s_add_u32 s78, s65, 0x80000
    s_lshl_b32 s65, s22, 9
    s_add_u32 s74, s65, 0x80000
    s_lshl_b32 s75, s22, 5
    s_getreg_b32 s65, hwreg(HW_REG_XCC_ID, 0, 4)
    s_mul_i32 s76, s65, s65
    s_lshl_b32 s76, s76, 15
    s_lshl_b32 s65, s65, 6
    s_add_u32 s65, s65, s76
    s_add_u32 s26, s65, 1
    s_waitcnt lgkmcnt(0)
    s_barrier
    s_mov_b32 s52, s20
    s_mov_b32 s53, s21
    s_mov_b32 s54, 0x100000
    s_mov_b32 s55, 0x20000
    s_mov_b32 s60, s18
    s_mov_b32 s61, s19
    s_mov_b32 s62, 0x100
    s_mov_b32 s63, 0x20000
    s_mov_b32 s56, s16
    s_mov_b32 s57, s17
    s_mov_b32 s58, 0x2000
    s_mov_b32 s59, 0x20000
    buffer_load_dwordx4 v[76:79], v6, s[52:55], s64 offen sc1
    buffer_load_dwordx4 v[80:83], v6, s[52:55], s64 offen offset:1024 sc1
    buffer_load_dwordx4 v[84:87], v14, s[52:55], s74 offen sc1
    buffer_load_dwordx4 v[88:91], v14, s[52:55], s74 offen offset:256 sc1
    buffer_load_dwordx4 v[92:95], off, s[52:55], s78 sc1
    s_waitcnt vmcnt(0)
    s_mov_b64 exec, 1
    v_mov_b32 v13, s26
    buffer_atomic_add v13, off, s[60:63], s75 sc1
    s_mov_b64 exec, -1
    v_not_b32 v92, v92
    v_and_b32 v92, 1, v92
    v_not_b32 v93, v93
    v_and_b32 v93, 1, v93
    v_not_b32 v94, v94
    v_and_b32 v94, 1, v94
    v_not_b32 v95, v95
    v_and_b32 v95, 1, v95
    s_mov_b32 s27, 131072
L_poll0:
    s_sleep 8
    ds_read_b32 v13, v12 offset:128
    s_waitcnt lgkmcnt(0)
    v_readfirstlane_b32 s77, v13
    s_sub_u32 s27, s27, 1
    s_cbranch_scc1 L_poll0_done
    s_cmp_lt_u32 s77, 4
    s_cbranch_scc1 L_poll0
L_poll0_done:
    ds_read_b128 v[16:19], v12 offset:0
    ds_read_b128 v[20:23], v12 offset:16
    ds_read_b128 v[24:27], v12 offset:32
    ds_read_b128 v[28:31], v12 offset:48
    s_waitcnt lgkmcnt(0)
    v_max3_f32 v32, v16, v20, v24
    v_max3_f32 v34, v18, v22, v26
    v_max_f32 v32, v32, v28
    v_max_f32 v34, v34, v30
    v_and_b32 v32, -2, v32
    v_and_b32 v34, -2, v34
    v_sub_f32 v36, v16, v32
    v_sub_f32 v37, v18, v34
    v_sub_f32 v38, v20, v32
    v_sub_f32 v39, v22, v34
    v_sub_f32 v40, v24, v32
    v_sub_f32 v41, v26, v34
    v_sub_f32 v42, v28, v32
    v_sub_f32 v43, v30, v34
    v_exp_f32 v36, v36
    v_exp_f32 v37, v37
    v_exp_f32 v38, v38
    v_exp_f32 v39, v39
    v_exp_f32 v40, v40
    v_exp_f32 v41, v41
    v_exp_f32 v42, v42
    v_exp_f32 v43, v43
    s_nop 0
    v_mul_f32 v33, v36, v17
    v_mul_f32 v35, v37, v19
    v_fmac_f32 v33, v38, v21
    v_fmac_f32 v35, v39, v23
    v_fmac_f32 v33, v40, v25
    v_fmac_f32 v35, v41, v27
    v_fmac_f32 v33, v42, v29
    v_fmac_f32 v35, v43, v31
    v_and_or_b32 v32, v32, -2, v92
    v_and_or_b32 v33, v33, -2, v93
    v_and_or_b32 v34, v34, -2, v94
    v_and_or_b32 v35, v35, -2, v95
    s_mov_b64 exec, 1
    ds_write_b128 v12, v[36:39] offset:64
    ds_write_b128 v12, v[40:43] offset:80
    s_mov_b32 s27, 131072
L_poll1:
    buffer_load_dword v13, off, s[60:63], s75 sc1
    s_waitcnt vmcnt(0)
    v_readfirstlane_b32 s77, v13
    s_sub_u32 s27, s27, 1
    s_cbranch_scc1 L_poll1_done
    s_and_b32 s76, s77, 63
    s_cmp_ge_u32 s76, 32
    s_cbranch_scc1 L_poll1_done
    s_sleep 32
    s_branch L_poll1
L_poll1_done:
    s_lshl_b32 s26, s26, 5
    s_cmp_eq_u32 s77, s26
    s_cselect_b32 s26, 1, 0
    v_mov_b32 v13, s26
    ds_write_b32 v12, v13 offset:96
    s_cmp_eq_u32 s26, 0
    s_cbranch_scc1 L_ml_far
    buffer_store_dwordx4 v[32:35], off, s[52:55], s78
    s_branch L_ml_done
L_ml_far:
    buffer_store_dwordx4 v[32:35], off, s[52:55], s78 sc0 sc1
L_ml_done:
    s_mov_b64 exec, -1
    v_and_b32 v15, 3, v1
    v_lshlrev_b32 v15, 2, v15
    v_bfe_u32 v73, v1, 4, 1
    v_lshl_add_u32 v15, v73, 9, v15
    v_lshrrev_b32 v73, 5, v1
    v_lshl_add_u32 v15, v73, 1, v15
    s_mov_b32 s66, 0x000f000f
    s_mov_b32 s67, 0x000f000f
    s_lshl_b32 s65, s22, 10
    s_lshl_b32 s76, s23, 4
    s_add_u32 s79, s65, s76
    s_waitcnt lgkmcnt(0)
    s_cmp_lg_u32 s26, 0
    s_cbranch_scc1 L_w
    s_barrier
L_w:
    s_mov_b32 s27, 131072
L_poll3:
    buffer_load_dwordx4 v[44:47], v14, s[52:55], s74 offen sc1
    buffer_load_dwordx4 v[48:51], v14, s[52:55], s74 offen offset:256 sc1
    s_waitcnt vmcnt(0)
    v_xor_b32 v72, v44, v84
    v_xor_b32 v73, v48, v88
    v_bitop3_b32 v72, v45, v85, v72 bitop3:0x28
    v_bitop3_b32 v73, v49, v89, v73 bitop3:0x28
    v_bitop3_b32 v72, v46, v86, v72 bitop3:0x28
    v_bitop3_b32 v73, v50, v90, v73 bitop3:0x28
    v_bitop3_b32 v72, v47, v87, v72 bitop3:0x28
    v_bitop3_b32 v73, v51, v91, v73 bitop3:0x28
    v_bitop3_b32 v72, v72, v73, 1 bitop3:0x80
    v_cmp_eq_u32 vcc, 0, v72
    s_cbranch_vccz L_poll3_done
    s_sub_u32 s27, s27, 1
    s_cbranch_scc1 L_poll3_done
    s_sleep 32
    s_branch L_poll3
L_poll3_done:
    v_and_b32 v44, -2, v44
    v_and_b32 v45, -2, v45
    v_and_b32 v46, -2, v46
    v_and_b32 v47, -2, v47
    v_and_b32 v48, -2, v48
    v_and_b32 v49, -2, v49
    v_and_b32 v50, -2, v50
    v_and_b32 v51, -2, v51
    v_max_f32 v52, v44, v48
    v_max_f32 v53, v46, v50
    s_nop 1
    v_max_f32_dpp v52, v52, v52 row_ror:4 row_mask:0xf bank_mask:0xf
    v_max_f32_dpp v53, v53, v53 row_ror:4 row_mask:0xf bank_mask:0xf
    s_nop 1
    v_max_f32_dpp v52, v52, v52 row_ror:8 row_mask:0xf bank_mask:0xf
    v_max_f32_dpp v53, v53, v53 row_ror:8 row_mask:0xf bank_mask:0xf
    v_mov_b32 v56, v52
    v_mov_b32 v57, v53
    s_nop 1
    v_permlane16_swap_b32 v56, v52
    v_permlane16_swap_b32 v57, v53
    s_nop 0
    v_max_f32 v52, v52, v56
    v_max_f32 v53, v53, v57
    v_mov_b32 v56, v52
    v_mov_b32 v57, v53
    s_nop 1
    v_permlane32_swap_b32 v56, v52
    v_permlane32_swap_b32 v57, v53
    s_nop 0
    v_max_f32 v52, v52, v56
    v_max_f32 v53, v53, v57
    v_sub_f32 v44, v44, v52
    v_sub_f32 v46, v46, v53
    v_sub_f32 v48, v48, v52
    v_sub_f32 v50, v50, v53
    v_exp_f32 v44, v44
    v_exp_f32 v46, v46
    v_exp_f32 v48, v48
    v_exp_f32 v50, v50
    s_nop 0
    v_mul_f32 v54, v44, v45
    v_mul_f32 v55, v46, v47
    v_fmac_f32 v54, v48, v49
    v_fmac_f32 v55, v50, v51
    s_nop 1
    v_add_f32_dpp v54, v54, v54 row_ror:4 row_mask:0xf bank_mask:0xf
    v_add_f32_dpp v55, v55, v55 row_ror:4 row_mask:0xf bank_mask:0xf
    s_nop 1
    v_add_f32_dpp v54, v54, v54 row_ror:8 row_mask:0xf bank_mask:0xf
    v_add_f32_dpp v55, v55, v55 row_ror:8 row_mask:0xf bank_mask:0xf
    v_mov_b32 v56, v54
    v_mov_b32 v57, v55
    s_nop 1
    v_permlane16_swap_b32 v56, v54
    v_permlane16_swap_b32 v57, v55
    s_nop 0
    v_add_f32 v54, v54, v56
    v_add_f32 v55, v55, v57
    v_mov_b32 v56, v54
    v_mov_b32 v57, v55
    s_nop 1
    v_permlane32_swap_b32 v56, v54
    v_permlane32_swap_b32 v57, v55
    s_nop 0
    v_add_f32 v54, v54, v56
    v_add_f32 v55, v55, v57
    v_rcp_f32 v54, v54
    v_rcp_f32 v55, v55
    s_nop 0
    v_mul_f32 v44, v44, v54
    v_mul_f32 v46, v46, v55
    v_mul_f32 v48, v48, v54
    v_mul_f32 v50, v50, v55
    s_mov_b32 s27, 131072
    s_cmp_eq_u32 s26, 0
    s_cbranch_scc1 L_poll2
    s_barrier
L_poll2:
    buffer_load_dwordx4 v[64:67], v6, s[52:55], s64 offen sc1
    buffer_load_dwordx4 v[68:71], v6, s[52:55], s64 offen offset:1024 sc1
L_poll2_chk:
    s_sub_u32 s27, s27, 1
    s_cbranch_scc1 L_poll2_done
    s_waitcnt vmcnt(0)
    v_xor_b32 v72, v64, v76
    v_xor_b32 v73, v68, v80
    v_bitop3_b32 v72, v65, v77, v72 bitop3:0x28
    v_bitop3_b32 v73, v69, v81, v73 bitop3:0x28
    v_bitop3_b32 v72, v66, v78, v72 bitop3:0x28
    v_bitop3_b32 v73, v70, v82, v73 bitop3:0x28
    v_bitop3_b32 v72, v67, v79, v72 bitop3:0x28
    v_bitop3_b32 v73, v71, v83, v73 bitop3:0x28
    v_bitop3_b32 v72, v72, v73, 1 bitop3:0x80
    v_cmp_eq_u32 vcc, 0, v72
    s_cbranch_vccz L_poll2_done
    s_mov_b64 exec, vcc
    s_branch L_poll2
L_poll2_done:
    s_mov_b64 exec, -1
    s_waitcnt vmcnt(0)
    v_and_b32 v64, -2, v64
    v_and_b32 v65, -2, v65
    v_and_b32 v66, -2, v66
    v_and_b32 v67, -2, v67
    v_and_b32 v68, -2, v68
    v_and_b32 v69, -2, v69
    v_and_b32 v70, -2, v70
    v_and_b32 v71, -2, v71
    v_mul_f32 v64, v64, v44
    v_mul_f32 v65, v65, v46
    v_mul_f32 v66, v66, v44
    v_mul_f32 v67, v67, v46
    v_fmac_f32 v64, v68, v48
    v_fmac_f32 v65, v69, v50
    v_fmac_f32 v66, v70, v48
    v_fmac_f32 v67, v71, v50
    s_nop 0
    v_permlane16_swap_b32 v64, v65
    v_permlane16_swap_b32 v66, v67
    s_nop 0
    v_add_f32 v64, v64, v65
    v_add_f32 v66, v66, v67
    s_nop 1
    v_permlane32_swap_b32 v64, v66
    s_nop 0
    v_add_f32 v64, v64, v66
    s_nop 1
    v_add_f32_dpp v64, v64, v64 row_ror:4 row_mask:0xf bank_mask:0xf
    s_nop 1
    v_add_f32_dpp v64, v64, v64 row_ror:8 row_mask:0xf bank_mask:0xf
    s_mov_b64 exec, s[66:67]
    v_cvt_pk_bf16_f32 v72, v64, v64
    buffer_store_short v72, v15, s[56:59], s79 offen
    s_mov_b64 exec, -1
L_end:
L_exit:
    s_endpgm
.section .rodata,"a"
.p2align 6
.amdhsa_kernel standalone__tree_speculative_verify_tree_attention_over_candidate_token_tree__decode_kernel
  .amdhsa_next_free_vgpr 224
  .amdhsa_next_free_sgpr 102
  .amdhsa_accum_offset 224
  .amdhsa_group_segment_fixed_size 0
  .amdhsa_kernarg_size 72
  .amdhsa_user_sgpr_count 2
  .amdhsa_user_sgpr_kernarg_segment_ptr 1
  .amdhsa_system_sgpr_workgroup_id_x 1
  .amdhsa_float_denorm_mode_32 3
.end_amdhsa_kernel
```
